```python
import torch

def _softmax(x, axis=-1):
    return torch.softmax(x, dim=axis)
def _gelu(x):
    return torch.nn.functional.gelu(x, approximate="tanh")
def _silu(x):
    return torch.nn.functional.silu(x)
def _sigmoid(x):
    return torch.sigmoid(x)
def _layernorm(x, axis=-1, eps=1e-5):
    m = x.mean(dim=axis, keepdim=True)
    v = x.var(dim=axis, keepdim=True, unbiased=False)
    return (x - m) / torch.sqrt(v + eps)
def _scatter_add(tgt, idx, src, axis=0):
    return tgt.clone().index_add_(axis, idx, src)
def _segment_sum(src, seg, n):
    out = torch.zeros((n,) + src.shape[1:], dtype=src.dtype)
    return out.index_add_(0, seg, src)
def _pad(x, pw):
    flat = tuple(v for pair in reversed(pw) for v in pair)
    return torch.nn.functional.pad(x, flat)

kernel_name = 'standalone__paged_block_table_kv_pagedattention__sampling'

def setup_inputs():

    _w = (lambda a: (lambda t: t.to(torch.bfloat16) if t.is_floating_point() else t)(torch.as_tensor(a)))
    B, Hq, Hkv, Sq, Skv, D = 32, 32, 16, 16, 2048, 128
    bs = 16
    nbps = max(1, Skv // bs)
    num_phys = B * nbps + 4
    bt = torch.randperm(num_phys)[: B * nbps].reshape(B, nbps).to(torch.int64)
    cl = (nbps * bs - (torch.arange(1, B + 1, dtype=torch.int64) * 2654435761) % max(1, nbps * bs // 2)).to(torch.int64)
    return {
        "q": _w((lambda *s: torch.randn(*s, dtype=torch.bfloat16) * 0.8)(B, Hq, Sq, D)),
        "k_cache": _w((lambda *s: torch.randn(*s, dtype=torch.bfloat16) * 0.8)(num_phys, bs, Hkv, D)),
        "v_cache": _w((lambda *s: torch.randn(*s, dtype=torch.bfloat16) * 0.05)(num_phys, bs, Hkv, D)),
        "block_table": _w(bt),
        "context_lens": _w(cl),
    }

def reference(q, k_cache, v_cache, block_table, context_lens):
    B, Hq, Sq, D = q.shape
    bs = k_cache.shape[1]
    Hkv = k_cache.shape[2]
    nbps = block_table.shape[1]
    Skv = nbps * bs
    bt = block_table.reshape(-1)
    k = (lambda x, *d: x.permute(*d))(k_cache[bt].reshape(B, Skv, Hkv, D), 0, 2, 1, 3)
    v = (lambda x, *d: x.permute(*d))(v_cache[bt].reshape(B, Skv, Hkv, D), 0, 2, 1, 3)
    g = Hq // Hkv
    qg = q.reshape(B, Hkv, g, Sq, D)
    scores = torch.einsum("bhgqd,bhkd->bhgqk", qg, k) * (D ** -0.5)
    pos = torch.arange(Skv)
    msk = pos[None, :] < context_lens[:, None]
    scores = torch.where(msk[:, None, None, None, :], scores, -1e9)
    p = _softmax(scores, axis=-1)
    out = torch.einsum("bhgqk,bhkd->bhgqd", p, v)
    return out.reshape(B, Hq, Sq, D)
```

```asm
; @launch grid=(256,1,1) block=(320,1,1) lds=163008
.amdgcn_target "amdgcn-amd-amdhsa--gfx950"
.text
.globl standalone__paged_block_table_kv_pagedattention__sampling_kernel
.p2align 8
.type standalone__paged_block_table_kv_pagedattention__sampling_kernel,@function
standalone__paged_block_table_kv_pagedattention__sampling_kernel:
    s_load_dwordx16 s[4:19], s[0:1], 0
    s_getpc_b64 s[20:21]
    v_mul_u32_u24 v1, 24, v0
    global_load_dword v31, v1, s[20:21]
    v_lshrrev_b32 v1, 6, v0
    v_and_b32 v0, 63, v0
    v_readfirstlane_b32 s36, v1
    s_cmpk_ge_u32 s2, 256
    s_cbranch_scc1 L_end
    s_lshl_b32 s67, s2, 3
    s_bitcmp1_b32 s2, 3
    s_cselect_b32 s68, 0xc2b291e, 0
    s_cselect_b32 s69, 0x27101c1a, 0
    s_cselect_b32 s68, s68, 0x55425712
    s_cselect_b32 s69, s69, 0x440e5340
    s_lshr_b64 s[68:69], s[68:69], s67
    s_lshr_b32 s69, s68, 2
    s_and_b32 s69, s69, 24
    s_lshr_b32 s69, 0x18110b, s69
    s_sub_u32 s69, s69, s68
    s_and_b32 s68, s68, 31
    s_and_b32 s69, s69, 31
    s_lshl_b32 s66, s68, 9
    s_lshl_b32 s67, s69, 9
    s_lshl_b32 s68, s68, 2
    s_lshl_b32 s69, s69, 2
    s_cmp_lt_u32 s36, 3
    s_cselect_b32 s70, s66, s67
    s_lshr_b32 s37, s2, 4
    s_andn2_b32 s71, 1, s36
    s_lshl1_add_u32 s63, s37, s71
    s_lshl4_add_u32 s63, s63, s70
    s_lshl_b32 s63, s63, 8
    v_lshl_add_u32 v1, v0, 4, s63
    s_lshl_b32 m0, s36, 12
    v_lshl_add_u32 v13, v0, 3, s70
    s_waitcnt lgkmcnt(0)
    s_load_dwordx8 s[84:91], s[10:11], s66
    s_load_dwordx8 s[92:99], s[10:11], s67
    s_load_dword s40, s[12:13], s68
    s_load_dword s41, s[12:13], s69
    global_load_dwordx2 v[32:33], v13, s[10:11]
    global_load_lds_dwordx4 v1, s[4:5] offset:0 nt
    global_load_lds_dwordx4 v1, s[4:5] offset:1024 nt
    global_load_lds_dwordx4 v1, s[4:5] offset:2048 nt
    global_load_lds_dwordx4 v1, s[4:5] offset:3072 nt
L_head_end:
    v_and_b32 v2, 15, v0
    v_lshrrev_b32 v3, 4, v0
    s_lshl_b32 s70, s37, 8
    v_mov_b32 v12, 149504
    s_mov_b32 s61, 0x400000
    s_mov_b32 s23, 0x20000
    s_mov_b32 s27, 0x20000
    s_add_u32 s52, s6, s70
    s_addc_u32 s53, s7, 0
    s_add_u32 s54, s8, s70
    s_addc_u32 s55, s9, 0
    v_lshlrev_b32 v13, 1, v3
    v_xor_b32 v13, v2, v13
    v_lshlrev_b32 v13, 4, v13
    v_mul_u32_u24 v14, 5, v3
    v_and_b32 v14, 9, v14
    v_lshl_add_u32 v4, v14, 12, v13
    s_cmp_lg_u32 s36, 0
    s_cbranch_scc1 L_consumer
    s_setprio 3
    v_mov_b32 v14, 0
    v_lshl_add_u32 v13, v2, 2, v12
    ds_write_b32 v13, v14
    v_xor_b32 v5, 128, v4
    v_add_u32 v5, 7168, v5
    v_add_u32 v6, 14336, v4
    v_xor_b32 v7, 128, v4
    v_add_u32 v7, 21504, v7
    s_mov_b32 s22, 61696
    s_mov_b32 s26, s22
    s_mov_b32 m0, 67584
    s_getreg_b32 s6, hwreg(HW_REG_XCC_ID)
    s_and_b32 s3, s2, 7
    s_lshl_b32 s3, s3, 12
    v_and_b32 v24, 31, v0
    v_lshl_add_u32 v24, v24, 2, s3
    v_lshrrev_b32 v28, 5, v0
    v_sub_u32 v29, 0, v28
    v_mov_b32 v26, 0
    v_mov_b32 v27, 0
    s_mov_b32 s44, 0x3151315a
    s_mov_b32 s45, 0x31513151
    s_lshl_b32 s3, s6, 3
    s_lshr_b64 s[44:45], s[44:45], s3
    s_and_b32 s3, s44, 0xff
    s_lshl_b32 s6, s3, 2
    s_movk_i32 s38, 256
    s_mov_b32 s75, 0
    s_lshr_b32 s33, s2, 3
    s_lshl_b64 s[0:1], 1, s33
    s_movk_i32 s60, 256
    s_movk_i32 s39, 256
    s_mov_b32 s31, 0
    s_mov_b64 s[56:57], s[52:53]
    s_waitcnt lgkmcnt(0)
    s_sub_u32 s66, s40, 1
    s_sub_u32 s67, s41, 1
    s_min_u32 s66, s66, s67
    s_cmp_ge_u32 s66, 128
    s_cselect_b32 s28, 1, 0
    s_cbranch_scc0 L_ld_nohead
    s_lshl_b32 s66, s84, 16
    s_lshl_b32 s67, s85, 16
    s_add_u32 s20, s52, s66
    s_addc_u32 s21, s53, 0
    s_add_u32 s24, s52, s67
    s_addc_u32 s25, s53, 0
    buffer_load_dwordx4 v4, s[20:23], 0 offen offset:0 nt lds
    buffer_load_dwordx4 v5, s[20:23], 0 offen offset:1024 nt lds
    buffer_load_dwordx4 v6, s[20:23], 0 offen offset:2048 nt lds
    buffer_load_dwordx4 v7, s[20:23], 0 offen offset:3072 nt lds
    s_mov_b32 m0, 71680
    s_nop 0
    buffer_load_dwordx4 v4, s[24:27], 0 offen offset:0 nt lds
    buffer_load_dwordx4 v5, s[24:27], 0 offen offset:1024 nt lds
    buffer_load_dwordx4 v6, s[24:27], 0 offen offset:2048 nt lds
    buffer_load_dwordx4 v7, s[24:27], 0 offen offset:3072 nt lds
L_ld_nohead:
    s_barrier
    v_writelane_b32 v14, s84, 0
    v_writelane_b32 v15, s85, 0
    v_writelane_b32 v14, s92, 1
    v_writelane_b32 v15, s93, 1
    v_writelane_b32 v14, s86, 2
    v_writelane_b32 v15, s87, 2
    v_writelane_b32 v14, s94, 3
    v_writelane_b32 v15, s95, 3
    v_writelane_b32 v14, s88, 4
    v_writelane_b32 v15, s89, 4
    v_writelane_b32 v14, s96, 5
    v_writelane_b32 v15, s97, 5
    v_writelane_b32 v14, s90, 6
    v_writelane_b32 v15, s91, 6
    v_writelane_b32 v14, s98, 7
    v_writelane_b32 v15, s99, 7
    v_lshl_or_b32 v14, v14, 16, s22
    v_lshl_or_b32 v15, v15, 16, s22
    s_sub_u32 s40, s40, 1
    s_min_u32 s40, s40, 2047
    s_lshr_b32 s42, s40, 5
    s_sub_u32 s41, s41, 1
    s_min_u32 s41, s41, 2047
    s_lshr_b32 s43, s41, 5
    s_add_u32 s74, s42, s43
    s_add_u32 s74, s74, 2
    s_lshl_b32 s29, s74, 1
    s_sub_u32 s63, 512, s74
    s_mov_b32 s72, s74
L_piL:
    s_cmp_gt_u32 s72, 97
    s_cselect_b32 s66, 97, 0
    s_sub_u32 s72, s72, s66
    s_cmp_gt_u32 s72, 97
    s_cbranch_scc1 L_piL
    s_sub_u32 s74, s74, s72
    s_mov_b32 s73, 0
    s_mov_b32 s49, 0
    s_mov_b32 s48, s28
    s_mov_b32 s50, s72
    s_lshl_b32 s62, s28, 13
    s_add_u32 s62, s62, 67584
    s_mov_b32 m0, s62
    s_sub_u32 s30, s28, 2
    s_mov_b32 s34, 7
    s_cmp_eq_u32 s28, 0
    s_cbranch_scc1 L_ld_slow
    s_cmp_lt_u32 s72, 9
    s_cbranch_scc1 L_ld_slow
    v_readlane_b32 s67, v14, s48
    v_readlane_b32 s68, v15, s48
    s_add_u32 s48, s48, 1
    s_and_b32 s51, s68, 0xffff
    s_xor_b32 s68, s68, s51
    s_add_u32 s58, s56, s68
    s_addc_u32 s59, s57, 0
    s_and_b32 s22, s67, 0xffff
    s_xor_b32 s67, s67, s22
    s_add_u32 s20, s56, s67
    s_addc_u32 s21, s57, 0
    s_mov_b32 s35, s34
L_ldO1:
    s_waitcnt vmcnt(23)
    buffer_load_dwordx4 v4, s[20:23], 0 offen offset:0 nt lds
    s_mov_b64 s[24:25], s[58:59]
    s_mov_b32 s26, s51
    v_readlane_b32 s67, v14, s48
    v_readlane_b32 s68, v15, s48
    s_add_u32 s48, s48, 1
    s_waitcnt vmcnt(23)
    buffer_load_dwordx4 v5, s[20:23], 0 offen offset:1024 nt lds
    s_waitcnt vmcnt(23)
    buffer_load_dwordx4 v6, s[20:23], 0 offen offset:2048 nt lds
    s_and_b32 s51, s68, 0xffff
    s_xor_b32 s68, s68, s51
    s_add_u32 s58, s56, s68
    s_addc_u32 s59, s57, 0
    s_waitcnt vmcnt(23)
    buffer_load_dwordx4 v7, s[20:23], 0 offen offset:3072 nt lds
    s_add_u32 m0, m0, 4096
    s_waitcnt vmcnt(23)
    buffer_load_dwordx4 v4, s[24:27], 0 offen offset:0 nt lds
    ds_read_b128 v[20:23], v12 offset:16
    s_and_b32 s22, s67, 0xffff
    s_xor_b32 s67, s67, s22
    s_add_u32 s20, s56, s67
    s_addc_u32 s21, s57, 0
    s_add_u32 s62, s62, 8192
    s_cmp_eq_u32 s62, 149504
    s_cselect_b32 s62, 67584, s62
    s_waitcnt vmcnt(23)
    buffer_load_dwordx4 v5, s[24:27], 0 offen offset:1024 nt lds
    s_add_u32 s28, s28, 1
    s_waitcnt vmcnt(23)
    buffer_load_dwordx4 v6, s[24:27], 0 offen offset:2048 nt lds
    s_waitcnt lgkmcnt(0)
    v_min_u32 v18, v20, v21
    v_min3_u32 v18, v18, v22, v23
    s_nop 0
    v_readfirstlane_b32 s32, v18
    s_waitcnt vmcnt(23)
    buffer_load_dwordx4 v7, s[24:27], 0 offen offset:3072 nt lds
    s_max_i32 s31, s31, s30
    v_mov_b32 v13, s31
    s_add_u32 s30, s30, 1
    ds_write_b32 v12, v13
    s_and_b32 s39, s39, 0xff
    s_add_u32 s39, s39, s60
    s_mov_b32 m0, s62
    s_add_u32 s32, s32, 9
    s_min_u32 s32, s32, s35
    s_cmp_lt_u32 s28, s32
    s_cbranch_scc0 L_ld_stop
    s_lshr_b32 s66, s39, 8
    s_cmp_eq_u32 s66, 0
    s_cbranch_scc1 L_ldE0
    s_cmp_eq_u32 s66, 2
    s_cbranch_scc1 L_ldE2
L_ldE1:
    s_waitcnt vmcnt(23)
    buffer_load_dwordx4 v4, s[20:23], 0 offen offset:0 nt lds
    s_mov_b64 s[24:25], s[58:59]
    s_mov_b32 s26, s51
    v_readlane_b32 s67, v14, s48
    v_readlane_b32 s68, v15, s48
    s_add_u32 s48, s48, 1
    s_waitcnt vmcnt(23)
    buffer_load_dwordx4 v5, s[20:23], 0 offen offset:1024 nt lds
    s_add_u32 s63, s63, 1
    v_mov_b32 v25, s63
    s_mov_b64 exec, s[0:1]
    global_store_dword v24, v25, s[18:19]
    s_mov_b64 exec, -1
    global_load_dword v26, v24, s[18:19] sc1
    s_waitcnt vmcnt(23)
    buffer_load_dwordx4 v6, s[20:23], 0 offen offset:2048 nt lds
    s_and_b32 s51, s68, 0xffff
    s_xor_b32 s68, s68, s51
    s_add_u32 s58, s56, s68
    s_addc_u32 s59, s57, 0
    s_waitcnt vmcnt(23)
    buffer_load_dwordx4 v7, s[20:23], 0 offen offset:3072 nt lds
    s_add_u32 m0, m0, 4096
    s_waitcnt vmcnt(23)
    buffer_load_dwordx4 v4, s[24:27], 0 offen offset:0 nt lds
    ds_read_b128 v[20:23], v12 offset:16
    s_and_b32 s22, s67, 0xffff
    s_xor_b32 s67, s67, s22
    s_add_u32 s20, s56, s67
    s_addc_u32 s21, s57, 0
    s_add_u32 s62, s62, 8192
    s_cmp_eq_u32 s62, 149504
    s_cselect_b32 s62, 67584, s62
    s_waitcnt vmcnt(23)
    buffer_load_dwordx4 v5, s[24:27], 0 offen offset:1024 nt lds
    s_add_u32 s28, s28, 1
    s_waitcnt vmcnt(23)
    buffer_load_dwordx4 v6, s[24:27], 0 offen offset:2048 nt lds
    s_waitcnt lgkmcnt(0)
    v_min_u32 v18, v20, v21
    v_min3_u32 v18, v18, v22, v23
    s_nop 0
    v_readfirstlane_b32 s32, v18
    v_readlane_b32 s71, v26, s33
    v_cmp_ne_u32 s[64:65], v26, v27
    s_nop 0
    v_subrev_u32 v30, s71, v26
    v_cmp_ge_i32 s[44:45], v30, v28
    v_cmp_lt_i32 s[46:47], v30, v29
    s_waitcnt vmcnt(23)
    buffer_load_dwordx4 v7, s[24:27], 0 offen offset:3072 nt lds
    s_max_i32 s31, s31, s30
    v_mov_b32 v13, s31
    s_add_u32 s30, s30, 1
    ds_write_b32 v12, v13
    s_and_b64 s[44:45], s[44:45], s[64:65]
    s_and_b64 s[46:47], s[46:47], s[64:65]
    s_bcnt1_i32_b64 s66, s[44:45]
    s_bcnt1_i32_b64 s71, s[46:47]
    s_sub_i32 s66, s66, s71
    s_sub_i32 s66, s66, 1
    s_mul_i32 s66, s66, s75
    s_add_i32 s66, s66, s38
    s_max_i32 s66, s66, 0
    s_min_i32 s60, s66, 512
    s_and_b32 s39, s39, 0xff
    s_add_u32 s39, s39, s60
    s_mov_b32 m0, s62
    s_add_u32 s32, s32, 9
    s_min_u32 s32, s32, s35
    s_cmp_lt_u32 s28, s32
    s_cbranch_scc0 L_ld_stop
    s_lshr_b32 s66, s39, 8
    s_cmp_eq_u32 s66, 0
    s_cbranch_scc1 L_ldO0
    s_cmp_eq_u32 s66, 1
    s_cbranch_scc1 L_ldO1
    s_branch L_ldO2
L_pad0:
    s_branch L_pad_ret
L_ldO0:
    s_waitcnt vmcnt(21)
    buffer_load_dwordx4 v4, s[20:23], 0 offen offset:0 nt lds
    s_mov_b64 s[24:25], s[58:59]
    s_mov_b32 s26, s51
    v_readlane_b32 s67, v14, s48
    v_readlane_b32 s68, v15, s48
    s_add_u32 s48, s48, 1
    s_waitcnt vmcnt(21)
    buffer_load_dwordx4 v5, s[20:23], 0 offen offset:1024 nt lds
    s_waitcnt vmcnt(21)
    buffer_load_dwordx4 v6, s[20:23], 0 offen offset:2048 nt lds
    s_and_b32 s51, s68, 0xffff
    s_xor_b32 s68, s68, s51
    s_add_u32 s58, s56, s68
    s_addc_u32 s59, s57, 0
    s_waitcnt vmcnt(21)
    buffer_load_dwordx4 v7, s[20:23], 0 offen offset:3072 nt lds
    s_add_u32 m0, m0, 4096
    s_waitcnt vmcnt(21)
    buffer_load_dwordx4 v4, s[24:27], 0 offen offset:0 nt lds
    ds_read_b128 v[20:23], v12 offset:16
    s_and_b32 s22, s67, 0xffff
    s_xor_b32 s67, s67, s22
    s_add_u32 s20, s56, s67
    s_addc_u32 s21, s57, 0
    s_add_u32 s62, s62, 8192
    s_cmp_eq_u32 s62, 149504
    s_cselect_b32 s62, 67584, s62
    s_waitcnt vmcnt(21)
    buffer_load_dwordx4 v5, s[24:27], 0 offen offset:1024 nt lds
    s_max_i32 s31, s31, s30
    v_mov_b32 v13, s31
    s_add_u32 s30, s30, 1
    ds_write_b32 v12, v13
    s_add_u32 s28, s28, 1
    s_waitcnt vmcnt(21)
    buffer_load_dwordx4 v6, s[24:27], 0 offen offset:2048 nt lds
    s_waitcnt lgkmcnt(1)
    v_min_u32 v18, v20, v21
    v_min3_u32 v18, v18, v22, v23
    s_nop 0
    v_readfirstlane_b32 s32, v18
    s_waitcnt vmcnt(21)
    buffer_load_dwordx4 v7, s[24:27], 0 offen offset:3072 nt lds
    s_and_b32 s39, s39, 0xff
    s_add_u32 s39, s39, s60
    s_mov_b32 m0, s62
    s_add_u32 s32, s32, 9
    s_min_u32 s32, s32, s35
    s_cmp_lt_u32 s28, s32
    s_cbranch_scc0 L_ld_stop
    s_lshr_b32 s66, s39, 8
    s_cmp_eq_u32 s66, 1
    s_cbranch_scc1 L_ldE1
    s_cmp_eq_u32 s66, 2
    s_cbranch_scc1 L_ldE2
L_ldE0:
    s_waitcnt vmcnt(21)
    buffer_load_dwordx4 v4, s[20:23], 0 offen offset:0 nt lds
    s_mov_b64 s[24:25], s[58:59]
    s_mov_b32 s26, s51
    v_readlane_b32 s67, v14, s48
    v_readlane_b32 s68, v15, s48
    s_add_u32 s48, s48, 1
    s_waitcnt vmcnt(21)
    buffer_load_dwordx4 v5, s[20:23], 0 offen offset:1024 nt lds
    s_add_u32 s63, s63, 1
    v_mov_b32 v25, s63
    s_mov_b64 exec, s[0:1]
    global_store_dword v24, v25, s[18:19]
    s_mov_b64 exec, -1
    global_load_dword v26, v24, s[18:19] sc1
    s_waitcnt vmcnt(21)
    buffer_load_dwordx4 v6, s[20:23], 0 offen offset:2048 nt lds
    s_and_b32 s51, s68, 0xffff
    s_xor_b32 s68, s68, s51
    s_add_u32 s58, s56, s68
    s_addc_u32 s59, s57, 0
    s_waitcnt vmcnt(21)
    buffer_load_dwordx4 v7, s[20:23], 0 offen offset:3072 nt lds
    s_add_u32 m0, m0, 4096
    s_waitcnt vmcnt(21)
    buffer_load_dwordx4 v4, s[24:27], 0 offen offset:0 nt lds
    ds_read_b128 v[20:23], v12 offset:16
    s_and_b32 s22, s67, 0xffff
    s_xor_b32 s67, s67, s22
    s_add_u32 s20, s56, s67
    s_addc_u32 s21, s57, 0
    s_add_u32 s62, s62, 8192
    s_cmp_eq_u32 s62, 149504
    s_cselect_b32 s62, 67584, s62
    s_waitcnt vmcnt(21)
    buffer_load_dwordx4 v5, s[24:27], 0 offen offset:1024 nt lds
    s_max_i32 s31, s31, s30
    v_mov_b32 v13, s31
    s_add_u32 s30, s30, 1
    ds_write_b32 v12, v13
    s_add_u32 s28, s28, 1
    s_waitcnt vmcnt(21)
    buffer_load_dwordx4 v6, s[24:27], 0 offen offset:2048 nt lds
    s_waitcnt lgkmcnt(1)
    v_min_u32 v18, v20, v21
    v_min3_u32 v18, v18, v22, v23
    s_nop 0
    v_readfirstlane_b32 s32, v18
    v_readlane_b32 s71, v26, s33
    v_cmp_ne_u32 s[64:65], v26, v27
    s_nop 0
    v_subrev_u32 v30, s71, v26
    v_cmp_ge_i32 s[44:45], v30, v28
    v_cmp_lt_i32 s[46:47], v30, v29
    s_waitcnt vmcnt(21)
    buffer_load_dwordx4 v7, s[24:27], 0 offen offset:3072 nt lds
    s_and_b64 s[44:45], s[44:45], s[64:65]
    s_and_b64 s[46:47], s[46:47], s[64:65]
    s_bcnt1_i32_b64 s66, s[44:45]
    s_bcnt1_i32_b64 s71, s[46:47]
    s_sub_i32 s66, s66, s71
    s_sub_i32 s66, s66, 1
    s_mul_i32 s66, s66, s75
    s_add_i32 s66, s66, s38
    s_max_i32 s66, s66, 0
    s_min_i32 s60, s66, 512
    s_and_b32 s39, s39, 0xff
    s_add_u32 s39, s39, s60
    s_mov_b32 m0, s62
    s_add_u32 s32, s32, 9
    s_min_u32 s32, s32, s35
    s_cmp_lt_u32 s28, s32
    s_cbranch_scc0 L_ld_stop
    s_lshr_b32 s66, s39, 8
    s_cmp_eq_u32 s66, 0
    s_cbranch_scc1 L_ldO0
    s_cmp_eq_u32 s66, 1
    s_cbranch_scc1 L_ldO1
    s_branch L_ldO2
L_pad1:
    s_branch L_pad_ret
L_ldO2:
    s_waitcnt vmcnt(25)
    buffer_load_dwordx4 v4, s[20:23], 0 offen offset:0 nt lds
    s_mov_b64 s[24:25], s[58:59]
    s_mov_b32 s26, s51
    v_readlane_b32 s67, v14, s48
    v_readlane_b32 s68, v15, s48
    s_add_u32 s48, s48, 1
    s_waitcnt vmcnt(25)
    buffer_load_dwordx4 v5, s[20:23], 0 offen offset:1024 nt lds
    s_sub_u32 s3, s30, 1
    s_max_i32 s31, s31, s3
    v_mov_b32 v13, s31
    s_add_u32 s30, s30, 1
    ds_write_b32 v12, v13
    s_waitcnt vmcnt(25)
    buffer_load_dwordx4 v6, s[20:23], 0 offen offset:2048 nt lds
    s_and_b32 s51, s68, 0xffff
    s_xor_b32 s68, s68, s51
    s_add_u32 s58, s56, s68
    s_addc_u32 s59, s57, 0
    s_waitcnt vmcnt(25)
    buffer_load_dwordx4 v7, s[20:23], 0 offen offset:3072 nt lds
    s_add_u32 m0, m0, 4096
    s_waitcnt vmcnt(25)
    buffer_load_dwordx4 v4, s[24:27], 0 offen offset:0 nt lds
    ds_read_b128 v[20:23], v12 offset:16
    s_and_b32 s22, s67, 0xffff
    s_xor_b32 s67, s67, s22
    s_add_u32 s20, s56, s67
    s_addc_u32 s21, s57, 0
    s_add_u32 s62, s62, 8192
    s_cmp_eq_u32 s62, 149504
    s_cselect_b32 s62, 67584, s62
    s_waitcnt vmcnt(25)
    buffer_load_dwordx4 v5, s[24:27], 0 offen offset:1024 nt lds
    s_add_u32 s28, s28, 1
    s_waitcnt vmcnt(25)
    buffer_load_dwordx4 v6, s[24:27], 0 offen offset:2048 nt lds
    s_waitcnt lgkmcnt(0)
    v_min_u32 v18, v20, v21
    v_min3_u32 v18, v18, v22, v23
    s_nop 0
    v_readfirstlane_b32 s32, v18
    s_waitcnt vmcnt(25)
    buffer_load_dwordx4 v7, s[24:27], 0 offen offset:3072 nt lds
    s_and_b32 s39, s39, 0xff
    s_add_u32 s39, s39, s60
    s_mov_b32 m0, s62
    s_add_u32 s32, s32, 9
    s_min_u32 s32, s32, s35
    s_cmp_lt_u32 s28, s32
    s_cbranch_scc0 L_ld_stop
    s_lshr_b32 s66, s39, 8
    s_cmp_eq_u32 s66, 0
    s_cbranch_scc1 L_ldE0
    s_cmp_eq_u32 s66, 1
    s_cbranch_scc1 L_ldE1
L_ldE2:
    s_waitcnt vmcnt(25)
    buffer_load_dwordx4 v4, s[20:23], 0 offen offset:0 nt lds
    s_mov_b64 s[24:25], s[58:59]
    s_mov_b32 s26, s51
    v_readlane_b32 s67, v14, s48
    v_readlane_b32 s68, v15, s48
    s_add_u32 s48, s48, 1
    s_waitcnt vmcnt(25)
    buffer_load_dwordx4 v5, s[20:23], 0 offen offset:1024 nt lds
    s_sub_u32 s3, s30, 1
    s_max_i32 s31, s31, s3
    v_mov_b32 v13, s31
    s_add_u32 s30, s30, 1
    ds_write_b32 v12, v13
    s_add_u32 s63, s63, 1
    v_mov_b32 v25, s63
    s_mov_b64 exec, s[0:1]
    global_store_dword v24, v25, s[18:19]
    s_mov_b64 exec, -1
    global_load_dword v26, v24, s[18:19] sc1
    s_waitcnt vmcnt(25)
    buffer_load_dwordx4 v6, s[20:23], 0 offen offset:2048 nt lds
    s_and_b32 s51, s68, 0xffff
    s_xor_b32 s68, s68, s51
    s_add_u32 s58, s56, s68
    s_addc_u32 s59, s57, 0
    s_waitcnt vmcnt(25)
    buffer_load_dwordx4 v7, s[20:23], 0 offen offset:3072 nt lds
    s_add_u32 m0, m0, 4096
    s_waitcnt vmcnt(25)
    buffer_load_dwordx4 v4, s[24:27], 0 offen offset:0 nt lds
    ds_read_b128 v[20:23], v12 offset:16
    s_and_b32 s22, s67, 0xffff
    s_xor_b32 s67, s67, s22
    s_add_u32 s20, s56, s67
    s_addc_u32 s21, s57, 0
    s_add_u32 s62, s62, 8192
    s_cmp_eq_u32 s62, 149504
    s_cselect_b32 s62, 67584, s62
    s_waitcnt vmcnt(25)
    buffer_load_dwordx4 v5, s[24:27], 0 offen offset:1024 nt lds
    s_add_u32 s28, s28, 1
    s_waitcnt vmcnt(25)
    buffer_load_dwordx4 v6, s[24:27], 0 offen offset:2048 nt lds
    s_waitcnt lgkmcnt(0)
    v_min_u32 v18, v20, v21
    v_min3_u32 v18, v18, v22, v23
    s_nop 0
    v_readfirstlane_b32 s32, v18
    v_readlane_b32 s71, v26, s33
    v_cmp_ne_u32 s[64:65], v26, v27
    s_nop 0
    v_subrev_u32 v30, s71, v26
    v_cmp_ge_i32 s[44:45], v30, v28
    v_cmp_lt_i32 s[46:47], v30, v29
    s_waitcnt vmcnt(25)
    buffer_load_dwordx4 v7, s[24:27], 0 offen offset:3072 nt lds
    s_and_b64 s[44:45], s[44:45], s[64:65]
    s_and_b64 s[46:47], s[46:47], s[64:65]
    s_bcnt1_i32_b64 s66, s[44:45]
    s_bcnt1_i32_b64 s71, s[46:47]
    s_sub_i32 s66, s66, s71
    s_sub_i32 s66, s66, 1
    s_mul_i32 s66, s66, s75
    s_add_i32 s66, s66, s38
    s_max_i32 s66, s66, 0
    s_min_i32 s60, s66, 512
    s_and_b32 s39, s39, 0xff
    s_add_u32 s39, s39, s60
    s_mov_b32 m0, s62
    s_add_u32 s32, s32, 9
    s_min_u32 s32, s32, s35
    s_cmp_lt_u32 s28, s32
    s_cbranch_scc0 L_ld_stop
    s_lshr_b32 s66, s39, 8
    s_cmp_eq_u32 s66, 0
    s_cbranch_scc1 L_ldO0
    s_cmp_eq_u32 s66, 1
    s_cbranch_scc1 L_ldO1
    s_branch L_ldO2
L_pad2:
    s_branch L_pad_ret
L_ld_stop:
    s_cmp_lt_u32 s28, s29
    s_cbranch_scc1 L_ld_s2
    s_sub_u32 s30, s29, 3
    s_max_i32 s31, s31, s30
    v_mov_b32 v13, s31
    s_waitcnt vmcnt(24)
    ds_write_b32 v12, v13
    s_add_u32 s30, s30, 1
    s_max_i32 s31, s31, s30
    v_mov_b32 v13, s31
    s_waitcnt vmcnt(16)
    ds_write_b32 v12, v13
    s_add_u32 s30, s30, 1
    s_max_i32 s31, s31, s30
    v_mov_b32 v13, s31
    s_waitcnt vmcnt(8)
    ds_write_b32 v12, v13
    s_add_u32 s30, s30, 1
    s_max_i32 s31, s31, s30
    v_mov_b32 v13, s31
    s_waitcnt vmcnt(0)
    ds_write_b32 v12, v13
    s_endpgm
L_ld_s2:
    s_cmp_lt_u32 s28, s35
    s_cbranch_scc1 L_ld_s4
    s_cmp_eq_u32 s28, s34
    s_cbranch_scc0 L_ld_s3
    v_readfirstlane_b32 s32, v18
    s_mov_b32 s38, s6
    s_cmp_lg_u32 s32, 0
    s_cbranch_scc1 L_ld_tabok
L_ld_tabA:
    ds_read_b128 v[20:23], v12 offset:16
    s_sub_u32 s61, s61, 1
    s_cbranch_scc1 L_end
    s_waitcnt lgkmcnt(0)
    v_min_u32 v18, v20, v21
    v_min3_u32 v18, v18, v22, v23
    s_nop 0
    v_readfirstlane_b32 s32, v18
    s_cmp_eq_u32 s32, 0
    s_cbranch_scc1 L_ld_tabA
L_ld_tabok:
    v_mov_b32 v27, v26
    s_mov_b32 s75, 16
    s_mov_b32 s34, -1
L_ld_s3:
    s_add_u32 s67, s28, 1
    s_cmp_eq_u32 s67, s50
    s_cbranch_scc0 L_ld_s3b
    s_xor_b32 s73, s73, 1
    s_cselect_b32 s48, s49, s48
    s_cselect_b64 s[56:57], s[54:55], s[52:53]
    s_cselect_b32 s72, s72, 97
    s_mov_b32 s49, s48
    s_add_u32 s50, s50, s72
L_ld_s3b:
    s_and_b32 s66, s48, 64
    s_lshl_b32 s66, s66, 3
    s_add_u32 s66, s66, 149568
    v_lshl_add_u32 v19, v0, 3, s66
    ds_read_b64 v[14:15], v19
    s_or_b32 s66, s48, 63
    s_sub_u32 s66, s66, s48
    s_add_u32 s66, s66, s67
    s_sub_u32 s35, s50, 1
    s_min_u32 s35, s35, s66
    s_min_u32 s35, s35, s29
    s_min_u32 s35, s35, s34
    s_waitcnt lgkmcnt(0)
L_ld_s4:
    s_cmp_lt_u32 s28, 9
    s_cbranch_scc1 L_ld_sel
    s_mov_b32 s67, 4
L_ld_chk:
    v_min_u32 v18, v20, v21
    v_min3_u32 v18, v18, v22, v23
    s_nop 0
    v_readfirstlane_b32 s32, v18
    s_add_u32 s32, s32, 9
    s_cmp_lt_u32 s28, s32
    s_cbranch_scc1 L_ld_sel
    s_sub_u32 s67, s67, 1
    s_cbranch_scc0 L_ld_rd
    s_waitcnt vmcnt(0)
    s_mov_b32 s31, s28
    v_mov_b32 v13, s31
    ds_write_b32 v12, v13
L_ld_rd:
    ds_read_b128 v[20:23], v12 offset:16
    s_sub_u32 s61, s61, 1
    s_cbranch_scc1 L_end
    s_waitcnt lgkmcnt(0)
    s_branch L_ld_chk
L_ld_sel:
    s_bitcmp1_b32 s28, 0
    s_cbranch_scc1 L_ld_selO
    s_lshr_b32 s66, s39, 8
    s_cmp_eq_u32 s66, 0
    s_cbranch_scc1 L_ldE0
    s_cmp_eq_u32 s66, 1
    s_cbranch_scc1 L_ldE1
    s_branch L_ldE2
L_ld_selO:
    s_lshr_b32 s66, s39, 8
    s_cmp_eq_u32 s66, 0
    s_cbranch_scc1 L_ldO0
    s_cmp_eq_u32 s66, 1
    s_cbranch_scc1 L_ldO1
    s_branch L_ldO2
L_ld_slow:
L_ld_tabB:
    ds_read_b128 v[20:23], v12 offset:16
    s_sub_u32 s61, s61, 1
    s_cbranch_scc1 L_end
    s_waitcnt lgkmcnt(0)
    v_min_u32 v18, v20, v21
    v_min3_u32 v18, v18, v22, v23
    s_nop 0
    v_readfirstlane_b32 s32, v18
    s_cmp_eq_u32 s32, 0
    s_cbranch_scc1 L_ld_tabB
    s_cmp_eq_u32 s28, s50
    s_cbranch_scc0 L_ld_slow1
    s_xor_b32 s73, s73, 1
    s_cselect_b32 s48, s49, s48
    s_cselect_b64 s[56:57], s[54:55], s[52:53]
    s_cselect_b32 s72, s72, 97
    s_mov_b32 s49, s48
    s_add_u32 s50, s50, s72
L_ld_slow1:
    s_and_b32 s66, s48, 64
    s_lshl_b32 s66, s66, 3
    s_add_u32 s66, s66, 149568
    v_lshl_add_u32 v19, v0, 3, s66
    ds_read_b64 v[14:15], v19
    s_waitcnt lgkmcnt(0)
    v_readlane_b32 s67, v14, s48
    v_readlane_b32 s68, v15, s48
    s_add_u32 s48, s48, 1
    s_and_b32 s51, s68, 0xffff
    s_xor_b32 s68, s68, s51
    s_add_u32 s58, s56, s68
    s_addc_u32 s59, s57, 0
    s_and_b32 s22, s67, 0xffff
    s_xor_b32 s67, s67, s22
    s_add_u32 s20, s56, s67
    s_addc_u32 s21, s57, 0
    s_branch L_ld_s3
L_consumer:
    s_sub_u32 s36, s36, 1
    s_lshr_b32 s29, s36, 1
    s_mov_b32 s20, s14
    s_mov_b32 s21, s15
    s_mov_b32 s22, 0x400000
    s_lshl_b32 s66, s36, 9
    s_add_u32 s66, s66, 20480
    v_mov_b32 v30, s66
    v_lshl_add_u32 v29, v0, 3, s66
    v_lshlrev_b32 v34, 1, v0
    v_or_b32 v35, 1, v34
    v_mov_b32 v28, 8
    v_subrev_u32 v13, 8, v34
    v_subrev_u32 v14, 8, v35
    s_cmp_eq_u32 s71, 0
    s_cselect_b64 vcc, 0, -1
    s_waitcnt lgkmcnt(0)
    s_cmp_lt_i32 s40, 1
    s_cselect_b32 s38, 1, 0
    s_sub_u32 s40, s40, 1
    s_min_u32 s40, s40, 2047
    s_lshr_b32 s42, s40, 5
    s_cmp_lt_i32 s41, 1
    s_cselect_b32 s39, 1, 0
    s_sub_u32 s41, s41, 1
    s_min_u32 s41, s41, 2047
    s_lshr_b32 s43, s41, 5
    s_cmp_eq_u32 s29, 0
    s_cselect_b32 s56, s40, s41
    s_cselect_b32 s84, s42, s43
    s_cselect_b32 s38, s38, s39
    s_and_b32 s56, s56, 31
    s_add_u32 s56, s56, 1
    s_and_b32 s3, s2, 15
    s_add_u32 s3, s3, 6
    s_min_u32 s62, s3, s84
    s_lshl_b32 s66, s84, 1
    s_sub_u32 s67, s66, 8
    s_max_i32 s67, s67, 0
    v_cmp_gt_u32 s[86:87], s67, v13
    v_cmp_gt_u32 s[88:89], s67, v14
    s_add_u32 s60, s66, 31
    s_lshr_b32 s60, s60, 5
    v_bfrev_b32 v13, 2
    s_cmp_eq_u32 s71, 0
    s_cselect_b64 s[90:91], s[86:87], s[88:89]
    s_barrier
    s_add_u32 s42, s42, 1
    s_add_u32 s43, s43, 1
    s_add_u32 s57, s84, 1
    s_add_u32 s74, s42, s43
    s_min_u32 s66, s42, s43
    s_min_u32 s66, s66, 4
    s_sub_u32 s67, s57, s66
    s_sub_u32 s68, s74, s57
    s_sub_u32 s68, s68, s66
    s_lshl_b32 s69, s67, 1
    v_cvt_f32_u32 v15, s69
    v_subrev_u32 v14, s66, v0
    v_rcp_f32 v15, v15
    v_lshl_or_b32 v14, v14, 1, 1
    s_add_u32 s67, s67, s29
    v_mul_u32_u24 v14, s68, v14
    v_add_u32 v14, s67, v14
    v_cvt_f32_u32 v14, v14
    v_cmp_gt_u32 s[92:93], s66, v0
    v_add_f32 v14, -0.5, v14
    v_mul_f32 v14, v14, v15
    v_cvt_u32_f32 v14, v14
    v_add3_u32 v11, v14, v0, s66
    v_lshl_add_u32 v14, v0, 1, s29
    v_cndmask_b32 v11, v11, v14, s[92:93]
    s_mov_b32 s72, s74
L_piC:
    s_cmp_gt_u32 s72, 97
    s_cselect_b32 s66, 97, 0
    s_sub_u32 s72, s72, s66
    s_cmp_gt_u32 s72, 97
    s_cbranch_scc1 L_piC
    s_sub_u32 s74, s74, s72
    s_mov_b32 s73, 0
    v_cmp_gt_u32 s[92:93], s72, v11
    v_cmp_gt_u32 s[94:95], s57, v0
    v_add_u32 v15, s72, v11
    v_add_u32 v14, 97, v15
    v_cndmask_b32 v9, v15, v11, s[92:93]
    v_cndmask_b32 v10, v14, v15, s[92:93]
    s_and_b64 s[92:93], s[92:93], s[94:95]
    s_bcnt1_i32_b64 s49, s[92:93]
    s_cselect_b32 s49, s49, s57
    s_mov_b32 s48, 0
    v_mul_u32_u24 v14, 6554, v9
    v_lshrrev_b32 v14, 16, v14
    v_mul_u32_u24 v14, 10, v14
    v_sub_u32 v14, v9, v14
    v_add_u32 v9, 1, v9
    v_lshl_or_b32 v9, v14, 13, v9
    v_mul_u32_u24 v14, 6554, v10
    v_lshrrev_b32 v14, 16, v14
    v_mul_u32_u24 v14, 10, v14
    v_sub_u32 v14, v10, v14
    v_add_u32 v10, 1, v10
    v_lshl_or_b32 v10, v14, 13, v10
    s_lshl_b32 s66, s71, 4
    s_sub_i32 s66, s56, s66
    s_min_i32 s66, s66, 16
    s_lshl_b32 s66, s66, 12
    s_sub_i32 s66, s66, 3840
    s_max_i32 s64, s66, 0
    s_cmp_eq_u32 s56, 32
    s_cselect_b32 s50, -1, s62
    v_readlane_b32 s32, v9, 0
    s_lshl_b32 s66, s36, 2
    s_add_u32 s66, s66, 149520
    v_mov_b32 v123, s66
    s_waitcnt vmcnt(4)
    v_lshl_or_b32 v36, v32, 7, v34
    v_lshl_or_b32 v37, v33, 7, v35
    v_cndmask_b32 v36, v13, v36, s[86:87]
    v_cndmask_b32 v37, v13, v37, s[88:89]
    ds_write_b64 v29, v[36:37]
    v_cndmask_b32 v32, v32, v33, vcc
    v_cndmask_b32 v38, v36, v37, vcc
    v_cndmask_b32 v34, v34, v35, vcc
    s_cmp_eq_u32 s60, 0
    s_cbranch_scc1 L_sort_done
L_sort:
    ds_read_b128 v[88:91], v30 offset:0
    ds_read_b128 v[92:95], v30 offset:16
    ds_read_b128 v[96:99], v30 offset:32
    ds_read_b128 v[100:103], v30 offset:48
    ds_read_b128 v[104:107], v30 offset:64
    ds_read_b128 v[108:111], v30 offset:80
    ds_read_b128 v[112:115], v30 offset:96
    ds_read_b128 v[116:119], v30 offset:112
    v_add_u32 v30, 128, v30
    s_waitcnt lgkmcnt(7)
    v_sub_u32 v88, v88, v38
    v_sub_u32 v89, v89, v38
    v_sub_u32 v90, v90, v38
    v_sub_u32 v91, v91, v38
    v_alignbit_b32 v39, v39, v88, 31
    v_alignbit_b32 v39, v39, v89, 31
    v_alignbit_b32 v39, v39, v90, 31
    v_alignbit_b32 v39, v39, v91, 31
    s_waitcnt lgkmcnt(6)
    v_sub_u32 v92, v92, v38
    v_sub_u32 v93, v93, v38
    v_sub_u32 v94, v94, v38
    v_sub_u32 v95, v95, v38
    v_alignbit_b32 v39, v39, v92, 31
    v_alignbit_b32 v39, v39, v93, 31
    v_alignbit_b32 v39, v39, v94, 31
    v_alignbit_b32 v39, v39, v95, 31
    s_waitcnt lgkmcnt(5)
    v_sub_u32 v96, v96, v38
    v_sub_u32 v97, v97, v38
    v_sub_u32 v98, v98, v38
    v_sub_u32 v99, v99, v38
    v_alignbit_b32 v39, v39, v96, 31
    v_alignbit_b32 v39, v39, v97, 31
    v_alignbit_b32 v39, v39, v98, 31
    v_alignbit_b32 v39, v39, v99, 31
    s_waitcnt lgkmcnt(4)
    v_sub_u32 v100, v100, v38
    v_sub_u32 v101, v101, v38
    v_sub_u32 v102, v102, v38
    v_sub_u32 v103, v103, v38
    v_alignbit_b32 v39, v39, v100, 31
    v_alignbit_b32 v39, v39, v101, 31
    v_alignbit_b32 v39, v39, v102, 31
    v_alignbit_b32 v39, v39, v103, 31
    s_waitcnt lgkmcnt(3)
    v_sub_u32 v104, v104, v38
    v_sub_u32 v105, v105, v38
    v_sub_u32 v106, v106, v38
    v_sub_u32 v107, v107, v38
    v_alignbit_b32 v39, v39, v104, 31
    v_alignbit_b32 v39, v39, v105, 31
    v_alignbit_b32 v39, v39, v106, 31
    v_alignbit_b32 v39, v39, v107, 31
    s_waitcnt lgkmcnt(2)
    v_sub_u32 v108, v108, v38
    v_sub_u32 v109, v109, v38
    v_sub_u32 v110, v110, v38
    v_sub_u32 v111, v111, v38
    v_alignbit_b32 v39, v39, v108, 31
    v_alignbit_b32 v39, v39, v109, 31
    v_alignbit_b32 v39, v39, v110, 31
    v_alignbit_b32 v39, v39, v111, 31
    s_waitcnt lgkmcnt(1)
    v_sub_u32 v112, v112, v38
    v_sub_u32 v113, v113, v38
    v_sub_u32 v114, v114, v38
    v_sub_u32 v115, v115, v38
    v_alignbit_b32 v39, v39, v112, 31
    v_alignbit_b32 v39, v39, v113, 31
    v_alignbit_b32 v39, v39, v114, 31
    v_alignbit_b32 v39, v39, v115, 31
    s_waitcnt lgkmcnt(0)
    v_sub_u32 v116, v116, v38
    v_sub_u32 v117, v117, v38
    v_sub_u32 v118, v118, v38
    v_sub_u32 v119, v119, v38
    v_alignbit_b32 v39, v39, v116, 31
    v_alignbit_b32 v39, v39, v117, 31
    v_alignbit_b32 v39, v39, v118, 31
    v_alignbit_b32 v39, v39, v119, 31
    s_sub_u32 s60, s60, 1
    v_bcnt_u32_b32 v28, v39, v28
    s_cmp_lg_u32 s60, 0
    s_cbranch_scc1 L_sort
L_sort_done:
    s_lshl_b32 s67, s62, 1
    v_cmp_le_u32 vcc, s67, v28
    v_cmp_eq_u32 s[86:87], s84, v0
    s_add_u32 s67, s67, s71
    v_add_u32 v14, 2, v28
    v_cndmask_b32 v28, v28, v14, vcc
    v_mov_b32 v14, s67
    v_cndmask_b32 v28, v34, v28, s[90:91]
    v_cndmask_b32 v28, v28, v14, s[86:87]
    v_lshlrev_b32 v14, 1, v28
    ds_bpermute_b32 v15, v14, v11
    v_mov_b32 v13, 61696
    v_mov_b32 v14, s64
    v_and_b32 v28, 1, v28
    v_cndmask_b32 v13, v13, v14, s[86:87]
    v_lshlrev_b32 v28, 2, v28
    v_lshl_or_b32 v13, v32, 16, v13
    v_add_u32 v28, 149568, v28
    s_and_b32 s66, s32, 0x1fff
    v_mov_b32 v14, s66
    s_waitcnt lgkmcnt(0)
    v_lshl_add_u32 v28, v15, 3, v28
    s_mov_b64 exec, s[94:95]
    ds_write_b32 v28, v13
    s_mov_b64 exec, -1
    ds_write_b32 v123, v14
    s_cmp_eq_u32 s36, 3
    s_cbranch_scc1 L_pad2
    s_cmp_eq_u32 s36, 2
    s_cbranch_scc1 L_pad1
    s_cmp_eq_u32 s36, 1
    s_cbranch_scc1 L_pad0
L_pad_ret:
    s_mov_b32 s28, 0x3e0293ee
    v_and_b32 v14, 7, v2
    v_lshlrev_b32 v14, 1, v14
    v_xor_b32 v14, v14, v3
    v_lshlrev_b32 v14, 4, v14
    v_lshl_add_u32 v120, v2, 8, v14
    v_add_u32 v120, 67584, v120
    v_lshrrev_b32 v15, 2, v0
    v_and_b32 v14, 7, v15
    v_lshlrev_b32 v14, 5, v14
    v_lshl_add_u32 v121, v15, 8, v14
    v_and_b32 v14, 3, v0
    v_lshl_add_u32 v121, v14, 3, v121
    v_add_u32 v121, 67584, v121
    v_lshlrev_b32 v122, 1, v3
    s_mul_i32 s66, s29, 63488
    s_lshl_b32 s67, s71, 10
    s_add_u32 s66, s66, s67
    v_mul_u32_u24 v14, 5, v3
    v_bfe_u32 v14, v14, 1, 2
    v_and_b32 v15, 7, v0
    v_xor_b32 v14, v14, v15
    v_lshl_add_u32 v14, v14, 4, s66
    v_lshl_add_u32 v24, v15, 7, v14
    v_and_b32 v14, 8, v0
    v_lshl_add_u32 v24, v14, 8, v24
    v_xor_b32 v25, 64, v24
    v_lshrrev_b32 v14, 3, v0
    v_lshlrev_b32 v27, 4, v15
    v_lshl_add_u32 v27, v14, 8, v27
    v_xor_b32 v15, v15, v14
    v_lshl_add_u32 v15, v15, 4, s66
    v_lshl_add_u32 v26, v14, 7, v15
    s_cmp_eq_u32 s29, 0
    s_movk_i32 s51, -128
    s_cmovk_i32 s51, 128
    s_cselect_b32 s66, 150592, 0
    s_cselect_b32 s66, s66, 162880
    s_cselect_b32 s67, 0, 0
    s_cselect_b32 s67, s67, 65536
    s_lshl_b32 s68, s71, 6
    s_add_u32 s66, s66, s68
    s_lshl_b32 s68, s71, 10
    s_add_u32 s67, s67, s68
    v_lshl_add_u32 v5, v0, 4, s67
    v_lshl_add_u32 v6, v2, 2, s66
    v_mov_b32 v4, 0xff800000
    v_mov_b32 v11, 0
    v_mov_b32 v56, 0
    v_mov_b32 v57, 0
    v_mov_b32 v58, 0
    v_mov_b32 v59, 0
    v_mov_b32 v60, 0
    v_mov_b32 v61, 0
    v_mov_b32 v62, 0
    v_mov_b32 v63, 0
    v_mov_b32 v64, 0
    v_mov_b32 v65, 0
    v_mov_b32 v66, 0
    v_mov_b32 v67, 0
    v_mov_b32 v68, 0
    v_mov_b32 v69, 0
    v_mov_b32 v70, 0
    v_mov_b32 v71, 0
    v_mov_b32 v72, 0
    v_mov_b32 v73, 0
    v_mov_b32 v74, 0
    v_mov_b32 v75, 0
    v_mov_b32 v76, 0
    v_mov_b32 v77, 0
    v_mov_b32 v78, 0
    v_mov_b32 v79, 0
    v_mov_b32 v80, 0
    v_mov_b32 v81, 0
    v_mov_b32 v82, 0
    v_mov_b32 v83, 0
    v_mov_b32 v84, 0
    v_mov_b32 v85, 0
    v_mov_b32 v86, 0
    v_mov_b32 v87, 0
    s_mov_b32 s30, 0
    s_lshl_b32 s66, s36, 12
    s_add_u32 s66, s66, 4096
    v_lshl_add_u32 v14, v2, 8, s66
    v_lshl_add_u32 v14, v3, 4, v14
    s_waitcnt vmcnt(0)
    ds_read_b128 v[40:43], v14 offset:0
    ds_read_b128 v[44:47], v14 offset:64
    ds_read_b128 v[48:51], v14 offset:128
    ds_read_b128 v[52:55], v14 offset:192
    s_waitcnt lgkmcnt(0)
    s_cmp_eq_u32 s38, 0
    s_cbranch_scc1 L_phase
    v_mov_b32 v40, 0
    v_mov_b32 v41, 0
    v_mov_b32 v42, 0
    v_mov_b32 v43, 0
    v_mov_b32 v44, 0
    v_mov_b32 v45, 0
    v_mov_b32 v46, 0
    v_mov_b32 v47, 0
    v_mov_b32 v48, 0
    v_mov_b32 v49, 0
    v_mov_b32 v50, 0
    v_mov_b32 v51, 0
    v_mov_b32 v52, 0
    v_mov_b32 v53, 0
    v_mov_b32 v54, 0
    v_mov_b32 v55, 0
L_phase:
    v_readlane_b32 s34, v10, s48
    s_mov_b32 s35, s48
    s_mov_b32 s59, 0
    v_mov_b32 v7, v5
    v_mov_b32 v8, v6
    s_and_b32 s31, s32, 0x1fff
    s_xor_b32 s58, s32, s31
    v_add_u32 v16, s58, v120
    v_xor_b32 v17, 64, v16
    v_xor_b32 v18, 128, v16
    v_xor_b32 v19, 192, v16
L_K:
    s_cmp_lt_i32 s30, s31
    s_cbranch_scc1 L_pollK
L_goK:
    ds_read_b128 v[88:91], v16 offset:0
    ds_read_b128 v[104:107], v16 offset:4096
    ds_read_b128 v[92:95], v17 offset:0
    ds_read_b128 v[108:111], v17 offset:4096
    ds_read_b128 v[96:99], v18 offset:0
    ds_read_b128 v[112:115], v18 offset:4096
    ds_read_b128 v[100:103], v19 offset:0
    ds_read_b128 v[116:119], v19 offset:4096
L_Kb:
    s_add_u32 s70, s35, 1
    v_readlane_b32 s33, v9, s70
    ds_read_b32 v1, v12
    s_cmp_lt_u32 s70, s49
    s_cselect_b32 s33, s33, s34
    s_and_b32 s31, s33, 0x1fff
    s_xor_b32 s58, s33, s31
    v_add_u32 v16, s58, v120
    v_xor_b32 v17, 64, v16
    v_xor_b32 v18, 128, v16
    v_xor_b32 v19, 192, v16
    v_mov_b32 v13, s31
    s_waitcnt lgkmcnt(7)
    v_mfma_f32_16x16x32_bf16 v[32:35], v[88:91], v[40:43], 0
    v_mfma_f32_16x16x32_bf16 v[36:39], v[104:107], v[40:43], 0
    s_waitcnt lgkmcnt(5)
    v_mfma_f32_16x16x32_bf16 v[32:35], v[92:95], v[44:47], v[32:35]
    v_mfma_f32_16x16x32_bf16 v[36:39], v[108:111], v[44:47], v[36:39]
    s_waitcnt lgkmcnt(3)
    v_mfma_f32_16x16x32_bf16 v[32:35], v[96:99], v[48:51], v[32:35]
    v_mfma_f32_16x16x32_bf16 v[36:39], v[112:115], v[48:51], v[36:39]
    s_waitcnt lgkmcnt(0)
    ds_write_b32 v123, v13
    v_readfirstlane_b32 s30, v1
    v_mfma_f32_16x16x32_bf16 v[32:35], v[100:103], v[52:55], v[32:35]
    v_mfma_f32_16x16x32_bf16 v[36:39], v[116:119], v[52:55], v[36:39]
    s_cmp_lt_u32 s70, s49
    s_cselect_b32 s69, s30, -1
    s_cmp_ge_i32 s69, s31
    s_cselect_b32 s69, 1, 0
    s_cbranch_scc0 L_Knoe
    ds_read_b128 v[88:91], v16 offset:0
    ds_read_b128 v[104:107], v16 offset:4096
    ds_read_b128 v[92:95], v17 offset:0
    ds_read_b128 v[108:111], v17 offset:4096
    ds_read_b128 v[96:99], v18 offset:0
    ds_read_b128 v[112:115], v18 offset:4096
    ds_read_b128 v[100:103], v19 offset:0
    ds_read_b128 v[116:119], v19 offset:4096
L_Knoe:
    s_cmp_eq_u32 s35, s50
    s_nop 0
    s_cbranch_scc1 L_mask
L_mask_done:
    v_max3_f32 v13, v32, v33, v34
    v_max3_f32 v14, v35, v36, v37
    v_max3_f32 v13, v13, v38, v39
    v_max3_f32 v13, v13, v14, v4
    v_mov_b32 v14, v13
    s_nop 1
    v_permlane32_swap_b32 v14, v13
    v_max_f32 v13, v13, v14
    v_mov_b32 v14, v13
    s_nop 1
    v_permlane16_swap_b32 v14, v13
    v_max_f32 v13, v13, v14
    v_sub_f32 v14, v4, v13
    v_mul_f32 v14, s28, v14
    v_exp_f32 v15, v14
    v_mov_b32 v4, v13
    v_mul_f32 v13, s28, v13
    v_fma_f32 v32, v32, s28, -v13
    v_fma_f32 v33, v33, s28, -v13
    v_fma_f32 v34, v34, s28, -v13
    v_fma_f32 v35, v35, s28, -v13
    v_fma_f32 v36, v36, s28, -v13
    v_fma_f32 v37, v37, s28, -v13
    v_fma_f32 v38, v38, s28, -v13
    v_fma_f32 v39, v39, s28, -v13
    v_exp_f32 v32, v32
    v_exp_f32 v33, v33
    v_exp_f32 v34, v34
    v_exp_f32 v35, v35
    v_exp_f32 v36, v36
    v_exp_f32 v37, v37
    v_exp_f32 v38, v38
    v_exp_f32 v39, v39
    v_mul_f32 v11, v11, v15
    v_add_f32 v13, v32, v33
    v_add_f32 v14, v34, v35
    v_add_f32 v13, v13, v36
    v_add_f32 v14, v14, v37
    v_add_f32 v13, v13, v38
    v_add_f32 v14, v14, v39
    v_add_f32 v11, v11, v13
    v_add_f32 v11, v11, v14
    s_cmp_eq_u32 s70, s57
    s_cbranch_scc1 L_fold
L_fold_done:
    v_cvt_pk_bf16_f32 v28, v32, v33
    v_cvt_pk_bf16_f32 v29, v34, v35
    v_cvt_pk_bf16_f32 v30, v36, v37
    v_cvt_pk_bf16_f32 v31, v38, v39
    ds_write_b32 v8, v15
    s_cmp_lt_u32 s59, 132
    s_cbranch_scc0 L_Kspill
    s_set_gpr_idx_on s59, gpr_idx(DST)
    v_mov_b32 v124, v28
    v_mov_b32 v125, v29
    v_mov_b32 v126, v30
    v_mov_b32 v127, v31
    s_set_gpr_idx_off
L_Kparked:
    s_add_u32 s59, s59, 4
    v_add_u32 v8, s51, v8
    s_mov_b32 s35, s70
    s_cmp_lg_u32 s69, 0
    s_cbranch_scc1 L_Kb
    s_cmp_lt_u32 s35, s49
    s_cbranch_scc1 L_K
    v_readlane_b32 s34, v9, s49
    s_mov_b32 s35, s48
    s_mov_b32 s59, 0
    v_mov_b32 v7, v5
    v_mov_b32 v8, v6
    s_cmp_lt_u32 s49, s57
    s_cselect_b32 s34, s34, 0x1fff
L_V:
    ds_read_b32 v15, v8
    ds_read_b32 v1, v12
    s_cmp_lt_u32 s59, 132
    s_cbranch_scc1 L_Vreg
    ds_read_b128 v[28:31], v7
    v_lshl_add_u32 v7, s51, 4, v7
L_Vgot:
    s_and_b32 s31, s33, 0x1fff
    s_xor_b32 s58, s33, s31
    s_add_u32 s35, s35, 1
    v_readlane_b32 s33, v10, s35
    v_add_u32 v16, s58, v121
    v_xor_b32 v17, 32, v16
    v_xor_b32 v18, 64, v16
    v_xor_b32 v19, 96, v16
    v_xor_b32 v20, 128, v16
    v_xor_b32 v21, 160, v16
    v_xor_b32 v22, 192, v16
    v_xor_b32 v23, 224, v16
    v_add_u32 v8, s51, v8
    s_add_u32 s59, s59, 4
    s_cmp_lt_u32 s35, s49
    s_cselect_b32 s33, s33, s34
    s_and_b32 s66, s33, 0x1fff
    v_mov_b32 v13, s66
    s_waitcnt lgkmcnt(0)
    v_readfirstlane_b32 s30, v1
    v_cmp_neq_f32 vcc, 1.0, v15
    s_cmp_lt_i32 s30, s31
    s_cbranch_scc0 L_Vrdy
    s_cmp_eq_u64 vcc, 0
    s_cbranch_scc1 L_pollV
    v_mul_f32 v56, v56, v15
    v_mul_f32 v57, v57, v15
    v_mul_f32 v58, v58, v15
    v_mul_f32 v59, v59, v15
    v_mul_f32 v60, v60, v15
    v_mul_f32 v61, v61, v15
    v_mul_f32 v62, v62, v15
    v_mul_f32 v63, v63, v15
    v_mul_f32 v64, v64, v15
    v_mul_f32 v65, v65, v15
    v_mul_f32 v66, v66, v15
    v_mul_f32 v67, v67, v15
    v_mul_f32 v68, v68, v15
    v_mul_f32 v69, v69, v15
    v_mul_f32 v70, v70, v15
    v_mul_f32 v71, v71, v15
    v_mul_f32 v72, v72, v15
    v_mul_f32 v73, v73, v15
    v_mul_f32 v74, v74, v15
    v_mul_f32 v75, v75, v15
    v_mul_f32 v76, v76, v15
    v_mul_f32 v77, v77, v15
    v_mul_f32 v78, v78, v15
    v_mul_f32 v79, v79, v15
    v_mul_f32 v80, v80, v15
    v_mul_f32 v81, v81, v15
    v_mul_f32 v82, v82, v15
    v_mul_f32 v83, v83, v15
    v_mul_f32 v84, v84, v15
    v_mul_f32 v85, v85, v15
    v_mul_f32 v86, v86, v15
    v_mul_f32 v87, v87, v15
    s_mov_b64 vcc, 0
    s_cmp_lt_i32 s30, s31
    s_cbranch_scc1 L_pollV
L_goV:
L_Vrdy:
    ds_read_b64_tr_b16 v[88:89], v16 offset:0
    ds_read_b64_tr_b16 v[90:91], v16 offset:4096
    ds_read_b64_tr_b16 v[92:93], v17 offset:0
    ds_read_b64_tr_b16 v[94:95], v17 offset:4096
    ds_read_b64_tr_b16 v[96:97], v18 offset:0
    ds_read_b64_tr_b16 v[98:99], v18 offset:4096
    ds_read_b64_tr_b16 v[100:101], v19 offset:0
    ds_read_b64_tr_b16 v[102:103], v19 offset:4096
    ds_read_b64_tr_b16 v[104:105], v20 offset:0
    ds_read_b64_tr_b16 v[106:107], v20 offset:4096
    ds_read_b64_tr_b16 v[108:109], v21 offset:0
    ds_read_b64_tr_b16 v[110:111], v21 offset:4096
    ds_read_b64_tr_b16 v[112:113], v22 offset:0
    ds_read_b64_tr_b16 v[114:115], v22 offset:4096
    ds_read_b64_tr_b16 v[116:117], v23 offset:0
    ds_read_b64_tr_b16 v[118:119], v23 offset:4096
    s_cmp_lg_u64 vcc, 0
    s_cbranch_scc1 L_Vlate
L_Vmm:
    s_cmp_eq_u32 s35, s57
    s_cbranch_scc1 L_Vlast
    s_cmp_lt_u32 s35, s49
    s_waitcnt lgkmcnt(14)
    v_mfma_f32_16x16x32_bf16 v[56:59], v[88:91], v[28:31], v[56:59]
    s_waitcnt lgkmcnt(12)
    v_mfma_f32_16x16x32_bf16 v[60:63], v[92:95], v[28:31], v[60:63]
    s_waitcnt lgkmcnt(10)
    v_mfma_f32_16x16x32_bf16 v[64:67], v[96:99], v[28:31], v[64:67]
    s_waitcnt lgkmcnt(8)
    v_mfma_f32_16x16x32_bf16 v[68:71], v[100:103], v[28:31], v[68:71]
    s_waitcnt lgkmcnt(6)
    v_mfma_f32_16x16x32_bf16 v[72:75], v[104:107], v[28:31], v[72:75]
    s_waitcnt lgkmcnt(4)
    v_mfma_f32_16x16x32_bf16 v[76:79], v[108:111], v[28:31], v[76:79]
    s_waitcnt lgkmcnt(2)
    v_mfma_f32_16x16x32_bf16 v[80:83], v[112:115], v[28:31], v[80:83]
    s_waitcnt lgkmcnt(0)
    ds_write_b32 v123, v13
    v_mfma_f32_16x16x32_bf16 v[84:87], v[116:119], v[28:31], v[84:87]
    s_cbranch_scc1 L_V
    s_branch L_next_phase
L_Vlast:
    s_waitcnt lgkmcnt(14)
    v_mfma_f32_16x16x32_bf16 v[56:59], v[88:91], v[28:31], v[56:59]
    s_waitcnt lgkmcnt(12)
    v_mfma_f32_16x16x32_bf16 v[60:63], v[92:95], v[28:31], v[60:63]
    s_waitcnt lgkmcnt(10)
    v_mfma_f32_16x16x32_bf16 v[64:67], v[96:99], v[28:31], v[64:67]
    s_waitcnt lgkmcnt(8)
    v_mfma_f32_16x16x32_bf16 v[68:71], v[100:103], v[28:31], v[68:71]
    s_waitcnt lgkmcnt(6)
    v_mfma_f32_16x16x32_bf16 v[72:75], v[104:107], v[28:31], v[72:75]
    s_waitcnt lgkmcnt(4)
    v_mfma_f32_16x16x32_bf16 v[76:79], v[108:111], v[28:31], v[76:79]
    v_cvt_pk_bf16_f32 v40, v56, v57
    v_cvt_pk_bf16_f32 v41, v58, v59
    v_cvt_pk_bf16_f32 v42, v60, v61
    v_cvt_pk_bf16_f32 v43, v62, v63
    s_waitcnt lgkmcnt(2)
    v_mfma_f32_16x16x32_bf16 v[80:83], v[112:115], v[28:31], v[80:83]
    s_waitcnt lgkmcnt(0)
    v_mfma_f32_16x16x32_bf16 v[84:87], v[116:119], v[28:31], v[84:87]
    ds_write_b32 v123, v13
    v_permlane16_swap_b32 v40, v42
    v_permlane16_swap_b32 v41, v43
    ds_write_b128 v24, v[40:43]
    v_cvt_pk_bf16_f32 v44, v64, v65
    v_cvt_pk_bf16_f32 v45, v66, v67
    v_cvt_pk_bf16_f32 v46, v68, v69
    v_cvt_pk_bf16_f32 v47, v70, v71
    v_cvt_pk_bf16_f32 v48, v72, v73
    v_cvt_pk_bf16_f32 v49, v74, v75
    v_cvt_pk_bf16_f32 v50, v76, v77
    v_cvt_pk_bf16_f32 v51, v78, v79
    v_permlane16_swap_b32 v44, v46
    v_permlane16_swap_b32 v45, v47
    ds_write_b128 v25, v[44:47]
    ds_read_b128 v[88:91], v26 offset:0
    ds_read_b128 v[92:95], v26 offset:2048
    v_cvt_pk_bf16_f32 v52, v80, v81
    v_cvt_pk_bf16_f32 v53, v82, v83
    v_cvt_pk_bf16_f32 v54, v84, v85
    v_cvt_pk_bf16_f32 v55, v86, v87
    v_permlane16_swap_b32 v48, v50
    v_permlane16_swap_b32 v49, v51
    ds_write_b128 v24, v[48:51]
    v_permlane16_swap_b32 v52, v54
    v_permlane16_swap_b32 v53, v55
    ds_write_b128 v25, v[52:55]
    ds_read_b128 v[96:99], v26 offset:0
    ds_read_b128 v[100:103], v26 offset:2048
    s_waitcnt lgkmcnt(5)
    buffer_store_dwordx4 v[88:91], v27, s[20:23], s63 offen offset:0
    s_waitcnt lgkmcnt(4)
    buffer_store_dwordx4 v[92:95], v27, s[20:23], s63 offen offset:2048
    s_waitcnt lgkmcnt(1)
    buffer_store_dwordx4 v[96:99], v27, s[20:23], s63 offen offset:128
    s_waitcnt lgkmcnt(0)
    buffer_store_dwordx4 v[100:103], v27, s[20:23], s63 offen offset:2176
L_end:
    s_endpgm
L_pollK:
    ds_read_b32 v1, v12
    s_sub_u32 s61, s61, 1
    s_cbranch_scc1 L_end
    s_waitcnt lgkmcnt(0)
    v_readfirstlane_b32 s30, v1
    s_cmp_ge_i32 s30, s31
    s_cbranch_scc1 L_goK
    s_branch L_pollK
L_fold:
    v_mov_b32 v13, v11
    s_nop 1
    v_permlane32_swap_b32 v13, v11
    v_add_f32 v11, v11, v13
    v_mov_b32 v13, v11
    s_nop 1
    v_permlane16_swap_b32 v13, v11
    v_add_f32 v11, v11, v13
    v_rcp_f32 v11, v11
    s_nop 0
    v_mul_f32 v15, v15, v11
    v_mul_f32 v32, v32, v11
    v_mul_f32 v33, v33, v11
    v_mul_f32 v34, v34, v11
    v_mul_f32 v35, v35, v11
    v_mul_f32 v36, v36, v11
    v_mul_f32 v37, v37, v11
    v_mul_f32 v38, v38, v11
    v_mul_f32 v39, v39, v11
    s_branch L_fold_done
L_Kspill:
    ds_write_b128 v7, v[28:31]
    v_lshl_add_u32 v7, s51, 4, v7
    s_branch L_Kparked
L_Vreg:
    s_set_gpr_idx_on s59, gpr_idx(SRC0)
    v_mov_b32 v28, v124
    v_mov_b32 v29, v125
    v_mov_b32 v30, v126
    v_mov_b32 v31, v127
    s_set_gpr_idx_off
    s_branch L_Vgot
L_pollV:
    ds_read_b32 v1, v12
    s_sub_u32 s61, s61, 1
    s_cbranch_scc1 L_end
    s_waitcnt lgkmcnt(0)
    v_readfirstlane_b32 s30, v1
    s_cmp_ge_i32 s30, s31
    s_cbranch_scc1 L_goV
    s_branch L_pollV
L_Vlate:
    v_mul_f32 v56, v56, v15
    v_mul_f32 v57, v57, v15
    v_mul_f32 v58, v58, v15
    v_mul_f32 v59, v59, v15
    v_mul_f32 v60, v60, v15
    v_mul_f32 v61, v61, v15
    v_mul_f32 v62, v62, v15
    v_mul_f32 v63, v63, v15
    v_mul_f32 v64, v64, v15
    v_mul_f32 v65, v65, v15
    v_mul_f32 v66, v66, v15
    v_mul_f32 v67, v67, v15
    v_mul_f32 v68, v68, v15
    v_mul_f32 v69, v69, v15
    v_mul_f32 v70, v70, v15
    v_mul_f32 v71, v71, v15
    v_mul_f32 v72, v72, v15
    v_mul_f32 v73, v73, v15
    v_mul_f32 v74, v74, v15
    v_mul_f32 v75, v75, v15
    v_mul_f32 v76, v76, v15
    v_mul_f32 v77, v77, v15
    v_mul_f32 v78, v78, v15
    v_mul_f32 v79, v79, v15
    v_mul_f32 v80, v80, v15
    v_mul_f32 v81, v81, v15
    v_mul_f32 v82, v82, v15
    v_mul_f32 v83, v83, v15
    v_mul_f32 v84, v84, v15
    v_mul_f32 v85, v85, v15
    v_mul_f32 v86, v86, v15
    v_mul_f32 v87, v87, v15
    s_branch L_Vmm
L_next_phase:
    s_mov_b32 s48, s49
    s_mov_b32 s49, s57
    s_mov_b32 s32, s33
    s_branch L_phase
L_mask:
    v_sub_u32 v13, s56, v122
    v_mov_b32 v14, 0xff800000
    v_cmp_lt_i32 vcc, 0, v13
    s_nop 1
    v_cndmask_b32 v32, v14, v32, vcc
    v_cmp_lt_i32 vcc, 1, v13
    s_nop 1
    v_cndmask_b32 v33, v14, v33, vcc
    v_cmp_lt_i32 vcc, 8, v13
    s_nop 1
    v_cndmask_b32 v34, v14, v34, vcc
    v_cmp_lt_i32 vcc, 9, v13
    s_nop 1
    v_cndmask_b32 v35, v14, v35, vcc
    v_cmp_lt_i32 vcc, 16, v13
    s_nop 1
    v_cndmask_b32 v36, v14, v36, vcc
    v_cmp_lt_i32 vcc, 17, v13
    s_nop 1
    v_cndmask_b32 v37, v14, v37, vcc
    v_cmp_lt_i32 vcc, 24, v13
    s_nop 1
    v_cndmask_b32 v38, v14, v38, vcc
    v_cmp_lt_i32 vcc, 25, v13
    s_nop 1
    v_cndmask_b32 v39, v14, v39, vcc
    s_branch L_mask_done
    .if (L_head_end - standalone__paged_block_table_kv_pagedattention__sampling_kernel) > 256
    .error "head too long"
    .endif
    .if (. - standalone__paged_block_table_kv_pagedattention__sampling_kernel) < 7744
    .fill (7744 - (. - standalone__paged_block_table_kv_pagedattention__sampling_kernel)) / 4, 4, 0xbf810000
    .endif
.section .rodata,"a"
.p2align 6
.amdhsa_kernel standalone__paged_block_table_kv_pagedattention__sampling_kernel
  .amdhsa_next_free_vgpr 256
  .amdhsa_next_free_sgpr 100
  .amdhsa_accum_offset 256
  .amdhsa_group_segment_fixed_size 0
  .amdhsa_kernarg_size 64
  .amdhsa_user_sgpr_count 2
  .amdhsa_user_sgpr_kernarg_segment_ptr 1
  .amdhsa_system_sgpr_workgroup_id_x 1
.end_amdhsa_kernel
```
